```python
import torch

def _softmax(x, axis=-1):
    return torch.softmax(x, dim=axis)
def _gelu(x):
    return torch.nn.functional.gelu(x, approximate="tanh")
def _silu(x):
    return torch.nn.functional.silu(x)
def _sigmoid(x):
    return torch.sigmoid(x)
def _layernorm(x, axis=-1, eps=1e-5):
    m = x.mean(dim=axis, keepdim=True)
    v = x.var(dim=axis, keepdim=True, unbiased=False)
    return (x - m) / torch.sqrt(v + eps)
def _scatter_add(tgt, idx, src, axis=0):
    return tgt.clone().index_add_(axis, idx, src)
def _segment_sum(src, seg, n):
    out = torch.zeros((n,) + src.shape[1:], dtype=src.dtype)
    return out.index_add_(0, seg, src)
def _pad(x, pw):
    flat = tuple(v for pair in reversed(pw) for v in pair)
    return torch.nn.functional.pad(x, flat)

kernel_name = 'sequential_preLN__sliding_block_cached__glu_gated_bilinear__decode'

def setup_inputs():

    _w = (lambda a: (lambda t: t.to(torch.bfloat16) if t.is_floating_point() else t)(torch.as_tensor(a)))
    def _A_setup():
        B, Sq, D = 1, 1, 512
        Hq, Hkv, Sk, Dh = 32, 8, 65536, 128
        assert Hq % Hkv == 0, (Hq, Hkv)
        return {
            "x": _w((lambda *s: torch.randn(*s, dtype=torch.bfloat16) * 0.05)(B, Sq, D)),
            "k_cache": _w((lambda *s: torch.randn(*s, dtype=torch.bfloat16) * 1.6)(B, Hkv, Sk, Dh)),
            "v_cache": _w((lambda *s: torch.randn(*s, dtype=torch.bfloat16) * 0.8)(B, Hkv, Sk, Dh)),
            "wq": _w((lambda *s: torch.randn(*s, dtype=torch.bfloat16) * 1.6)(D, Hq * Dh) * (D ** -0.5)),
            "wo": _w((lambda *s: torch.randn(*s, dtype=torch.bfloat16) * 0.8)(Hq * Dh, D) * ((Hq * Dh) ** -0.5)),
        }
    _A_in = _A_setup()

    def _B_setup():
        B, S, D, F = 1, 1, 512, 1792
        return {
            "x": _w((lambda *s: torch.randn(*s, dtype=torch.bfloat16) * 0.05)(B, S, D)),
            "w_gate": _w((lambda *s: torch.randn(*s, dtype=torch.bfloat16) * 0.4)(D, F) * (D ** -0.5)),
            "w_up": _w((lambda *s: torch.randn(*s, dtype=torch.bfloat16) * 0.4)(D, F) * (D ** -0.5)),
            "w_down": _w((lambda *s: torch.randn(*s, dtype=torch.bfloat16) * 0.4)(F, D) * (F ** -0.5)),
        }
    _B_in = _B_setup()

    return {
        "A_x": _A_in["x"],
        "A_k_cache": _A_in["k_cache"],
        "A_v_cache": _A_in["v_cache"],
        "A_wq": _A_in["wq"],
        "A_wo": _A_in["wo"],
        "B_x": _B_in["x"],
        "B_w_gate": _B_in["w_gate"],
        "B_w_up": _B_in["w_up"],
        "B_w_down": _B_in["w_down"],
    }

def reference(A_x, A_k_cache, A_v_cache, A_wq, A_wo, B_x, B_w_gate, B_w_up, B_w_down):
    def _A_ref(x, k_cache, v_cache, wq, wo):
        B, Sq, D = x.shape
        Hq, Dh = 32, 128
        Hkv, Sk = k_cache.shape[1], k_cache.shape[2]
        W = min(4096, max(256, Sk // 4))
        rep = Hq // Hkv
        q = (lambda x, *d: x.permute(*d))((x @ wq).reshape(B, Sq, Hq, Dh), 0, 2, 1, 3)
        k = (lambda x, n, axis: torch.repeat_interleave(x, n, dim=axis))(k_cache[:, :, Sk - W:, :], rep, axis=1)
        v = (lambda x, n, axis: torch.repeat_interleave(x, n, dim=axis))(v_cache[:, :, Sk - W:, :], rep, axis=1)
        scores = torch.einsum("bhqd,bhkd->bhqk", q, k) * (Dh ** -0.5)
        p = _softmax(scores, axis=-1)
        o = torch.einsum("bhqk,bhkd->bhqd", p, v)
        return (lambda x, *d: x.permute(*d))(o, 0, 2, 1, 3).reshape(B, Sq, Hq * Dh) @ wo

    def _B_ref(x, w_gate, w_up, w_down):
        g = torch.einsum("bsd,df->bsf", x, w_gate)
        u = torch.einsum("bsd,df->bsf", x, w_up)
        h = g * u
        return torch.einsum("bsf,fd->bsd", h, w_down)

    x = A_x
    h = x + _A_ref(_layernorm(x, axis=-1), A_k_cache, A_v_cache, A_wq, A_wo)
    h2 = h + _B_ref(_layernorm(h, axis=-1), B_w_gate, B_w_up, B_w_down)
    return h2
```

```asm
; @launch grid=(256,1,1) block=(320,1,1) lds=72192
.amdgcn_target "amdgcn-amd-amdhsa--gfx950"
.text
.globl sequential_preLN__sliding_block_cached__glu_gated_bilinear__decode_kernel
.p2align 8
.type sequential_preLN__sliding_block_cached__glu_gated_bilinear__decode_kernel,@function
sequential_preLN__sliding_block_cached__glu_gated_bilinear__decode_kernel:
    s_load_dwordx16 s[4:19], s[0:1], 0
    s_load_dwordx8 s[20:27], s[0:1], 64
    s_getpc_b64 s[54:55]
L_pc:
    s_cmp_ge_u32 s2, 256
    s_cbranch_scc1 L_end
    v_lshlrev_b32 v40, 7, v0
    v_min_u32 v40, L_end-L_pc, v40
    global_load_dword v3, v40, s[54:55]
    v_lshrrev_b32 v2, 6, v0
    v_and_b32 v1, 63, v0
    v_readfirstlane_b32 s30, v2
    s_and_b32 s28, s2, 7
    s_lshr_b32 s29, s2, 3
    s_lshr_b32 s56, s2, 6
    v_lshlrev_b32 v10, 4, v1
    v_lshrrev_b32 v2, 4, v1
    s_cmp_lg_u32 s30, 0
    s_cbranch_scc1 L_att
    s_setprio 3
    s_movk_i32 s61, 0x2000
    s_and_b32 s57, s29, 7
    s_lshl_b32 s58, s56, 8
    v_and_b32 v11, 0x38, v1
    v_lshl_add_u32 v11, v11, 2, s58
    s_lshl_b32 s58, s28, 10
    s_lshl_b32 s59, s57, 7
    s_add_u32 s58, s58, s59
    v_and_b32 v12, 7, v1
    v_lshl_add_u32 v13, v12, 4, s58
    v_lshl_add_u32 v13, v11, 12, v13
    s_waitcnt lgkmcnt(0)
    global_load_dwordx4 v[16:19], v10, s[4:5]
    global_load_dwordx4 v[20:23], v11, s[4:5]
    global_load_dwordx4 v[24:27], v11, s[4:5] offset:16
    global_load_dwordx4 v[64:67], v13, s[10:11] nt
    v_add_u32 v13, s61, v13
    global_load_dwordx4 v[68:71], v13, s[10:11] nt
    v_add_u32 v13, s61, v13
    global_load_dwordx4 v[72:75], v13, s[10:11] nt
    v_add_u32 v13, s61, v13
    global_load_dwordx4 v[76:79], v13, s[10:11] nt
    v_add_u32 v13, s61, v13
    global_load_dwordx4 v[80:83], v13, s[10:11] nt
    v_add_u32 v13, s61, v13
    global_load_dwordx4 v[84:87], v13, s[10:11] nt
    v_add_u32 v13, s61, v13
    global_load_dwordx4 v[88:91], v13, s[10:11] nt
    v_add_u32 v13, s61, v13
    global_load_dwordx4 v[92:95], v13, s[10:11] nt
    v_add_u32 v13, s61, v13
    global_load_dwordx4 v[96:99], v13, s[10:11] nt
    v_add_u32 v13, s61, v13
    global_load_dwordx4 v[100:103], v13, s[10:11] nt
    v_add_u32 v13, s61, v13
    global_load_dwordx4 v[104:107], v13, s[10:11] nt
    v_add_u32 v13, s61, v13
    global_load_dwordx4 v[108:111], v13, s[10:11] nt
    v_add_u32 v13, s61, v13
    global_load_dwordx4 v[112:115], v13, s[10:11] nt
    v_add_u32 v13, s61, v13
    global_load_dwordx4 v[116:119], v13, s[10:11] nt
    v_add_u32 v13, s61, v13
    global_load_dwordx4 v[120:123], v13, s[10:11] nt
    v_add_u32 v13, s61, v13
    global_load_dwordx4 v[124:127], v13, s[10:11] nt
    s_barrier
    s_load_dwordx2 s[32:33], s[26:27], 0
    s_mov_b32 s60, 0xffff0000
    v_mov_b32 v9, 0xff
    v_and_b32 v42, 1, v1
    v_lshlrev_b32 v42, 4, v42
    v_mov_b32 v43, 0xffff
    v_lshlrev_b32 v42, v42, v43
    v_bfe_u32 v43, v1, 1, 2
    v_cmp_eq_u32 vcc, 0, v43
    s_nop 1
    v_cndmask_b32 v4, 0, v42, vcc
    v_cmp_eq_u32 vcc, 1, v43
    s_nop 1
    v_cndmask_b32 v5, 0, v42, vcc
    v_cmp_eq_u32 vcc, 2, v43
    s_nop 1
    v_cndmask_b32 v6, 0, v42, vcc
    v_cmp_eq_u32 vcc, 3, v43
    s_nop 1
    v_cndmask_b32 v7, 0, v42, vcc
    s_lshl_b32 s58, s28, 13
    s_lshl_b32 s59, s56, 11
    s_add_u32 s58, s58, s59
    s_lshl_b32 s59, s57, 8
    s_add_u32 s58, s58, s59
    s_add_u32 s58, s58, 65536
    v_lshl_add_u32 v56, v12, 5, s58
    v_and_b32 v57, 16, v1
    v_lshrrev_b32 v58, 5, v1
    v_add_u32 v56, v56, v57
    v_lshl_add_u32 v56, v58, 3, v56
    v_mul_u32_u24 v58, 14, v58
    v_add_u32 v57, 131072, v56
    s_waitcnt vmcnt(16)
    v_lshlrev_b32 v40, 16, v16
    v_and_b32 v41, s60, v16
    v_lshlrev_b32 v42, 16, v17
    v_and_b32 v43, s60, v17
    v_lshlrev_b32 v44, 16, v18
    v_and_b32 v45, s60, v18
    v_lshlrev_b32 v46, 16, v19
    v_and_b32 v47, s60, v19
    v_add_f32 v48, v40, v41
    v_add_f32 v49, v42, v43
    v_add_f32 v50, v44, v45
    v_add_f32 v51, v46, v47
    v_add_f32 v48, v48, v49
    v_add_f32 v50, v50, v51
    v_add_f32 v48, v48, v50
    v_lshlrev_b32 v28, 16, v20
    v_and_b32 v29, s60, v20
    v_add_f32_dpp v48, v48, v48 quad_perm:[1,0,3,2] row_mask:0xf bank_mask:0xf
    v_lshlrev_b32 v30, 16, v21
    v_and_b32 v31, s60, v21
    v_add_f32_dpp v48, v48, v48 quad_perm:[2,3,0,1] row_mask:0xf bank_mask:0xf
    v_lshlrev_b32 v32, 16, v22
    v_and_b32 v33, s60, v22
    v_add_f32_dpp v48, v48, v48 row_half_mirror row_mask:0xf bank_mask:0xf
    v_lshlrev_b32 v34, 16, v23
    v_and_b32 v35, s60, v23
    v_add_f32_dpp v48, v48, v48 row_mirror row_mask:0xf bank_mask:0xf
    v_lshlrev_b32 v36, 16, v24
    v_and_b32 v37, s60, v24
    v_add_f32_dpp v48, v48, v48 row_bcast:15 row_mask:0xa bank_mask:0xf
    v_lshlrev_b32 v38, 16, v25
    v_and_b32 v39, s60, v25
    v_add_f32_dpp v48, v48, v48 row_bcast:31 row_mask:0xc bank_mask:0xf
    v_mul_f32 v48, 0x3b000000, v48
    v_lshlrev_b32 v60, 16, v26
    v_and_b32 v61, s60, v26
    v_readlane_b32 s61, v48, 63
    v_lshlrev_b32 v62, 16, v27
    v_and_b32 v63, s60, v27
    v_cvt_pk_bf16_f32 v50, 0, s61
    v_subrev_f32 v40, s61, v40
    v_subrev_f32 v41, s61, v41
    v_subrev_f32 v42, s61, v42
    v_subrev_f32 v43, s61, v43
    v_subrev_f32 v44, s61, v44
    v_subrev_f32 v45, s61, v45
    v_subrev_f32 v46, s61, v46
    v_subrev_f32 v47, s61, v47
    v_mul_f32 v48, v40, v40
    v_mul_f32 v49, v41, v41
    v_fmac_f32 v48, v42, v42
    v_fmac_f32 v49, v43, v43
    v_fmac_f32 v48, v44, v44
    v_fmac_f32 v49, v45, v45
    v_fmac_f32 v48, v46, v46
    v_fmac_f32 v49, v47, v47
    v_add_f32 v48, v48, v49
    v_sub_f32 v28, v28, v50
    v_sub_f32 v29, v29, v50
    v_add_f32_dpp v48, v48, v48 quad_perm:[1,0,3,2] row_mask:0xf bank_mask:0xf
    v_sub_f32 v30, v30, v50
    v_sub_f32 v31, v31, v50
    v_add_f32_dpp v48, v48, v48 quad_perm:[2,3,0,1] row_mask:0xf bank_mask:0xf
    v_sub_f32 v32, v32, v50
    v_sub_f32 v33, v33, v50
    v_add_f32_dpp v48, v48, v48 row_half_mirror row_mask:0xf bank_mask:0xf
    v_sub_f32 v34, v34, v50
    v_sub_f32 v35, v35, v50
    v_add_f32_dpp v48, v48, v48 row_mirror row_mask:0xf bank_mask:0xf
    v_sub_f32 v36, v36, v50
    v_sub_f32 v37, v37, v50
    v_add_f32_dpp v48, v48, v48 row_bcast:15 row_mask:0xa bank_mask:0xf
    v_sub_f32 v38, v38, v50
    v_sub_f32 v39, v39, v50
    v_add_f32_dpp v48, v48, v48 row_bcast:31 row_mask:0xc bank_mask:0xf
    v_mul_f32 v48, 0x3b000000, v48
    v_sub_f32 v60, v60, v50
    v_sub_f32 v61, v61, v50
    v_sub_f32 v62, v62, v50
    v_sub_f32 v63, v63, v50
    v_cvt_pk_bf16_f32 v48, 0, v48
    v_add_f32 v48, 0x3727c5ac, v48
    v_cvt_pk_bf16_f32 v48, 0, v48
    v_sqrt_f32 v48, v48
    v_cvt_pk_bf16_f32 v28, 0, v28
    v_cvt_pk_bf16_f32 v48, 0, v48
    v_rcp_f32 v48, v48
    v_cvt_pk_bf16_f32 v29, 0, v29
    v_readlane_b32 s62, v48, 63
    v_cvt_pk_bf16_f32 v30, 0, v30
    v_cvt_pk_bf16_f32 v31, 0, v31
    v_cvt_pk_bf16_f32 v32, 0, v32
    v_cvt_pk_bf16_f32 v33, 0, v33
    v_cvt_pk_bf16_f32 v34, 0, v34
    v_cvt_pk_bf16_f32 v35, 0, v35
    v_cvt_pk_bf16_f32 v36, 0, v36
    v_cvt_pk_bf16_f32 v37, 0, v37
    v_cvt_pk_bf16_f32 v38, 0, v38
    v_cvt_pk_bf16_f32 v39, 0, v39
    v_cvt_pk_bf16_f32 v60, 0, v60
    v_cvt_pk_bf16_f32 v61, 0, v61
    v_cvt_pk_bf16_f32 v62, 0, v62
    v_cvt_pk_bf16_f32 v63, 0, v63
    s_waitcnt lgkmcnt(0)
    s_add_u32 s32, s32, 1
    s_addc_u32 s33, s33, 0
    s_getreg_b32 s3, hwreg(HW_REG_XCC_ID, 0, 4)
    s_lshl_b32 s59, s3, 28
    s_and_b32 s3, s32, 0x0fffffff
    s_or_b32 s3, s3, s59
    s_lshl_b32 s59, s28, 7
    s_add_u32 s59, s59, 4096
    s_add_u32 s48, s26, s59
    s_addc_u32 s49, s27, 0
    s_lshl_b32 s59, s29, 2
    v_mov_b32 v40, s59
    v_mov_b32 v41, s3
    s_mov_b64 exec, 1
    global_store_dword v40, v41, s[48:49] sc1
    s_mov_b64 exec, -1
    s_and_b32 s63, s32, 1
    v_lshrrev_b32 v58, v58, s32
    v_lshrrev_b32 v59, 7, v58
    v_and_b32 v58, 0xfe, v58
    v_and_b32 v59, 0xfe, v59
    v_or_b32 v58, s63, v58
    v_or_b32 v59, s63, v59
    v_mul_f32 v28, s62, v28
    v_mul_f32 v29, s62, v29
    v_mul_f32 v30, s62, v30
    v_mul_f32 v31, s62, v31
    v_mul_f32 v32, s62, v32
    v_mul_f32 v33, s62, v33
    v_mul_f32 v34, s62, v34
    v_mul_f32 v35, s62, v35
    v_mul_f32 v36, s62, v36
    v_mul_f32 v37, s62, v37
    v_mul_f32 v38, s62, v38
    v_mul_f32 v39, s62, v39
    v_mul_f32 v60, s62, v60
    v_mul_f32 v61, s62, v61
    v_mul_f32 v62, s62, v62
    v_mul_f32 v63, s62, v63
    v_cvt_pk_bf16_f32 v28, v28, v28
    v_cvt_pk_bf16_f32 v29, v29, v29
    v_cvt_pk_bf16_f32 v30, v30, v30
    v_cvt_pk_bf16_f32 v31, v31, v31
    v_cvt_pk_bf16_f32 v32, v32, v32
    v_cvt_pk_bf16_f32 v33, v33, v33
    v_cvt_pk_bf16_f32 v34, v34, v34
    v_cvt_pk_bf16_f32 v35, v35, v35
    v_cvt_pk_bf16_f32 v36, v36, v36
    v_cvt_pk_bf16_f32 v37, v37, v37
    v_cvt_pk_bf16_f32 v38, v38, v38
    v_cvt_pk_bf16_f32 v39, v39, v39
    v_cvt_pk_bf16_f32 v60, v60, v60
    v_cvt_pk_bf16_f32 v61, v61, v61
    v_cvt_pk_bf16_f32 v62, v62, v62
    v_cvt_pk_bf16_f32 v63, v63, v63
    v_and_b32 v128, v28, v4
    v_and_b32 v129, v28, v5
    v_and_b32 v130, v28, v6
    v_and_b32 v131, v28, v7
    v_and_b32 v132, v29, v4
    v_and_b32 v133, v29, v5
    v_and_b32 v134, v29, v6
    v_and_b32 v135, v29, v7
    s_waitcnt vmcnt(16)
    v_mfma_f32_16x16x32_bf16 v[52:55], v[128:131], v[64:67], 0
    v_and_b32 v136, v30, v4
    v_and_b32 v137, v30, v5
    v_and_b32 v138, v30, v6
    v_and_b32 v139, v30, v7
    s_waitcnt vmcnt(15)
    v_mfma_f32_16x16x32_bf16 v[52:55], v[132:135], v[68:71], v[52:55]
    v_and_b32 v140, v31, v4
    v_and_b32 v141, v31, v5
    v_and_b32 v142, v31, v6
    v_and_b32 v143, v31, v7
    s_waitcnt vmcnt(14)
    v_mfma_f32_16x16x32_bf16 v[52:55], v[136:139], v[72:75], v[52:55]
    v_and_b32 v144, v32, v4
    v_and_b32 v145, v32, v5
    v_and_b32 v146, v32, v6
    v_and_b32 v147, v32, v7
    s_waitcnt vmcnt(13)
    v_mfma_f32_16x16x32_bf16 v[52:55], v[140:143], v[76:79], v[52:55]
    v_and_b32 v148, v33, v4
    v_and_b32 v149, v33, v5
    v_and_b32 v150, v33, v6
    v_and_b32 v151, v33, v7
    s_waitcnt vmcnt(12)
    v_mfma_f32_16x16x32_bf16 v[52:55], v[144:147], v[80:83], v[52:55]
    v_and_b32 v152, v34, v4
    v_and_b32 v153, v34, v5
    v_and_b32 v154, v34, v6
    v_and_b32 v155, v34, v7
    s_waitcnt vmcnt(11)
    v_mfma_f32_16x16x32_bf16 v[52:55], v[148:151], v[84:87], v[52:55]
    v_and_b32 v156, v35, v4
    v_and_b32 v157, v35, v5
    v_and_b32 v158, v35, v6
    v_and_b32 v159, v35, v7
    s_waitcnt vmcnt(10)
    v_mfma_f32_16x16x32_bf16 v[52:55], v[152:155], v[88:91], v[52:55]
    v_and_b32 v160, v36, v4
    v_and_b32 v161, v36, v5
    v_and_b32 v162, v36, v6
    v_and_b32 v163, v36, v7
    s_waitcnt vmcnt(9)
    v_mfma_f32_16x16x32_bf16 v[52:55], v[156:159], v[92:95], v[52:55]
    v_and_b32 v164, v37, v4
    v_and_b32 v165, v37, v5
    v_and_b32 v166, v37, v6
    v_and_b32 v167, v37, v7
    s_waitcnt vmcnt(8)
    v_mfma_f32_16x16x32_bf16 v[52:55], v[160:163], v[96:99], v[52:55]
    v_and_b32 v168, v38, v4
    v_and_b32 v169, v38, v5
    v_and_b32 v170, v38, v6
    v_and_b32 v171, v38, v7
    s_waitcnt vmcnt(7)
    v_mfma_f32_16x16x32_bf16 v[52:55], v[164:167], v[100:103], v[52:55]
    v_and_b32 v172, v39, v4
    v_and_b32 v173, v39, v5
    v_and_b32 v174, v39, v6
    v_and_b32 v175, v39, v7
    s_waitcnt vmcnt(6)
    v_mfma_f32_16x16x32_bf16 v[52:55], v[168:171], v[104:107], v[52:55]
    v_and_b32 v176, v60, v4
    v_and_b32 v177, v60, v5
    v_and_b32 v178, v60, v6
    v_and_b32 v179, v60, v7
    s_waitcnt vmcnt(5)
    v_mfma_f32_16x16x32_bf16 v[52:55], v[172:175], v[108:111], v[52:55]
    v_and_b32 v180, v61, v4
    v_and_b32 v181, v61, v5
    v_and_b32 v182, v61, v6
    v_and_b32 v183, v61, v7
    s_waitcnt vmcnt(4)
    v_mfma_f32_16x16x32_bf16 v[52:55], v[176:179], v[112:115], v[52:55]
    v_and_b32 v184, v62, v4
    v_and_b32 v185, v62, v5
    v_and_b32 v186, v62, v6
    v_and_b32 v187, v62, v7
    s_waitcnt vmcnt(3)
    v_mfma_f32_16x16x32_bf16 v[52:55], v[180:183], v[116:119], v[52:55]
    v_and_b32 v188, v63, v4
    v_and_b32 v189, v63, v5
    v_and_b32 v190, v63, v6
    v_and_b32 v191, v63, v7
    s_waitcnt vmcnt(2)
    v_mfma_f32_16x16x32_bf16 v[52:55], v[184:187], v[120:123], v[52:55]
    s_waitcnt vmcnt(1)
    v_mfma_f32_16x16x32_bf16 v[52:55], v[188:191], v[124:127], v[52:55]
    s_nop 7
    v_permlane32_swap_b32 v52, v54
    v_permlane32_swap_b32 v53, v55
    s_nop 0
    v_add_f32_dpp v52, v54, v52 row_ror:8 row_mask:0xf bank_mask:0xf
    v_add_f32_dpp v53, v55, v53 row_ror:8 row_mask:0xf bank_mask:0xf
    s_mov_b32 exec_lo, 0xff00ff
    s_mov_b32 exec_hi, 0xff00ff
    v_add_u32 v52, 0x80, v52
    v_add_u32 v53, 0x80, v53
    v_bfi_b32 v52, v9, v58, v52
    v_bfi_b32 v53, v9, v59, v53
    global_store_dwordx2 v56, v[52:53], s[26:27]
    global_store_dwordx2 v57, v[52:53], s[26:27] sc1
    s_endpgm
L_att:
    s_sub_u32 s30, s30, 1
    s_lshl_b32 s59, s29, 2
    s_add_u32 s59, s59, s30
    s_mul_i32 s58, s28, 5
    s_add_u32 s59, s59, s58
    s_and_b32 s59, s59, 127
    s_lshl_b32 s59, s59, 10
    s_lshl_b32 s58, s28, 24
    s_add_u32 s58, s58, s59
    s_lshl_b32 s31, s30, 13
    s_add_u32 s58, s58, 0xF01000
    v_and_b32 v14, 15, v1
    v_xor_b32 v24, v14, v2
    v_lshlrev_b32 v24, 4, v24
    v_lshl_add_u32 v24, v2, 8, v24
    v_xor_b32 v25, 64, v24
    v_xor_b32 v26, 0x80, v24
    v_xor_b32 v27, 0xc0, v24
    s_add_u32 m0, s31, 4096
    s_waitcnt lgkmcnt(0)
    s_add_u32 s44, s6, s58
    s_addc_u32 s45, s7, 0
    s_barrier
    global_load_lds_dwordx4 v24, s[44:45] offset:-4096 nt
    s_add_u32 s44, s44, 130048
    s_addc_u32 s45, s45, 0
    global_load_lds_dwordx4 v25, s[44:45] offset:-3072 nt
    s_add_u32 s44, s44, 130048
    s_addc_u32 s45, s45, 0
    global_load_lds_dwordx4 v26, s[44:45] offset:-2048 nt
    s_add_u32 s44, s44, 130048
    s_addc_u32 s45, s45, 0
    global_load_lds_dwordx4 v27, s[44:45] offset:-1024 nt
    s_add_u32 s44, s44, 130048
    s_addc_u32 s45, s45, 0
    global_load_lds_dwordx4 v24, s[44:45] offset:0 nt
    s_add_u32 s44, s44, 130048
    s_addc_u32 s45, s45, 0
    global_load_lds_dwordx4 v25, s[44:45] offset:1024 nt
    s_add_u32 s44, s44, 130048
    s_addc_u32 s45, s45, 0
    global_load_lds_dwordx4 v26, s[44:45] offset:2048 nt
    s_add_u32 s44, s44, 130048
    s_addc_u32 s45, s45, 0
    global_load_lds_dwordx4 v27, s[44:45] offset:3072 nt
    s_load_dwordx2 s[32:33], s[26:27], 0
    s_add_u32 s46, s8, s58
    s_addc_u32 s47, s9, 0
    v_lshrrev_b32 v40, 1, v14
    v_xor_b32 v40, v40, v2
    v_and_b32 v41, 1, v14
    v_lshl_add_u32 v40, v40, 1, v41
    v_lshlrev_b32 v40, 4, v40
    v_lshl_add_u32 v28, v2, 8, v40
    v_xor_b32 v29, 0x80, v28
    s_add_u32 m0, s31, 36864
    v_lshrrev_b32 v30, 5, v1
    v_and_b32 v31, 31, v1
    v_and_b32 v32, 3, v1
    v_bfe_u32 v33, v1, 2, 2
    v_lshlrev_b32 v35, 4, v14
    v_lshlrev_b32 v41, 7, v1
    s_lshl_b32 s69, s28, 16
    s_and_b32 s57, s29, 15
    s_lshl_b32 s72, s28, 15
    s_lshr_b32 s74, s28, 1
    s_mul_i32 s74, s74, 896
    s_and_b32 s68, s28, 1
    s_lshl_b32 s58, s68, 9
    s_add_u32 s74, s74, s58
    s_lshl_b32 s78, s28, 11
    s_add_u32 s78, s78, 131072
    s_lshl_b32 s79, s28, 8
    s_add_u32 s79, s79, 147456
    s_cmp_ge_u32 s29, 16
    s_cbranch_scc1 L_setR
    s_lshl_b32 s71, s57, 10
    s_add_u32 s71, s71, 1835008
    v_and_b32 v39, 7, v1
    s_lshl_b32 s58, s28, 7
    s_add_u32 s58, s58, s71
    v_lshlrev_b32 v36, 4, v39
    v_lshl_add_u32 v36, v2, 2, v36
    v_add_u32 v197, s58, v36
    v_lshl_add_u32 v37, v39, 7, s71
    v_lshl_add_u32 v37, v2, 5, v37
    v_and_b32 v36, 8, v1
    v_lshl_add_u32 v196, v36, 1, v37
    s_lshl_b32 s58, s57, 6
    v_lshl_add_u32 v201, v2, 4, s58
    v_and_b32 v36, 12, v1
    v_add_u32 v201, v201, v36
    s_add_u32 s58, s69, 262144
    v_lshl_add_u32 v195, v39, 4, s58
    v_lshrrev_b32 v36, 3, v1
    v_lshl_add_u32 v195, v36, 12, v195
    v_xor_b32 v36, s57, v36
    v_lshl_add_u32 v195, v36, 7, v195
    v_xor_b32 v193, 0x8400, v195
    s_lshl_b32 s62, s57, 4
    s_add_u32 s62, s62, s79
    v_mov_b32 v199, s62
    s_and_b32 s59, s30, 1
    s_lshl_b32 s58, s59, 8
    s_add_u32 s58, s58, s74
    s_mul_i32 s62, s57, 114688
    s_add_u32 s58, s58, s62
    v_mul_u32_u24 v13, 28672, v2
    v_add3_u32 v13, v13, v35, s58
    s_and_b32 s62, s59, s68
    s_cselect_b32 s86, 0x00ff00ff, -1
    s_mov_b32 s87, s86
    s_movk_i32 s61, 3584
    s_mov_b32 s90, -1
    s_cmp_lt_u32 s30, 2
    s_cselect_b32 s76, s16, s18
    s_cselect_b32 s77, s17, s19
    s_lshl_b32 s58, s59, 14
    s_add_u32 s58, s58, s72
    s_lshl_b32 s62, s57, 7
    s_add_u32 s58, s58, s62
    s_lshr_b32 s62, s30, 1
    s_lshl_b32 s62, s62, 5
    s_add_u32 s58, s58, s62
    s_add_u32 s58, s58, 1048576
    v_lshrrev_b32 v36, 1, v14
    v_lshl_add_u32 v198, v36, 11, s58
    v_and_b32 v36, 1, v1
    v_lshl_add_u32 v198, v36, 6, v198
    v_lshl_add_u32 v198, v2, 4, v198
    v_and_b32 v37, 14, v1
    v_lshlrev_b32 v37, 6, v37
    s_lshl_b32 s58, s59, 10
    v_xor_b32 v37, s58, v37
    v_xor_b32 v198, v198, v37
    s_mov_b32 s84, 1
    s_mov_b32 s85, 0
    v_mov_b32_e64 v194, 0
    s_lshl_b32 s58, s59, 3
    s_xor_b32 s63, s58, s57
    s_add_u32 s58, s62, s69
    s_lshl_b32 s59, s57, 12
    s_add_u32 s58, s58, s59
    s_add_u32 s58, s58, 264192
    v_lshl_add_u32 v204, v36, 6, s58
    v_lshl_add_u32 v204, v2, 4, v204
    v_bfe_u32 v36, v1, 1, 3
    v_xor_b32 v36, s63, v36
    v_lshl_add_u32 v204, v36, 7, v204
    v_mov_b32 v203, v199
    s_branch L_setD
L_setR:
    s_lshl_b32 s59, s57, 12
    s_add_u32 s59, s59, s69
    s_lshr_b32 s75, s59, 1
    s_add_u32 s75, s75, 1048576
    s_add_u32 s70, s59, 262144
    s_lshl_b32 s58, s30, 5
    s_add_u32 s58, s58, s70
    v_lshrrev_b32 v36, 1, v1
    v_and_b32 v37, 1, v1
    v_lshl_add_u32 v193, v36, 7, s58
    v_lshl_add_u32 v193, v37, 4, v193
    s_lshl_b32 s62, s57, 8
    v_xor_b32 v193, s62, v193
    s_lshr_b32 s62, s57, 2
    s_lshl_b32 s62, s62, 9
    s_add_u32 s73, s78, s62
    v_lshl_add_u32 v194, v36, 4, s73
    s_lshl_b32 s58, s30, 10
    s_add_u32 s58, s58, 68096
    v_add_u32 v38, s58, v10
    v_mov_b32 v44, 0
    v_mov_b32 v45, 0
    v_mov_b32 v46, 0
    v_mov_b32 v47, 0
    ds_write_b128 v38, v[44:47]
    v_lshlrev_b32 v200, 7, v2
    v_add_u32 v200, 68096, v200
    s_add_u32 s91, s57, s28
    s_and_b32 s91, s91, 7
    s_lshl_b32 s58, s30, 1
    s_sub_u32 s58, s58, s91
    v_add_u32 v37, s58, v37
    v_and_b32 v37, 7, v37
    v_lshl_add_u32 v196, v37, 9, v200
    v_and_b32 v36, 7, v36
    v_mad_u32_u24 v196, v36, 18, v196
    v_and_b32 v36, 7, v1
    v_lshl_add_u32 v200, v36, 4, v200
    v_and_b32 v37, 16, v1
    v_lshl_add_u32 v38, v14, 5, v37
    s_lshl_b32 s58, s30, 9
    s_lshl_b32 s59, s57, 7
    s_xor_b32 s58, s58, s59
    v_xor_b32 v38, s58, v38
    v_add_u32 v195, s70, v38
    s_lshl_b32 s58, s30, 16
    s_lshl_b32 s59, s28, 9
    s_add_u32 s58, s58, s59
    s_lshl_b32 s59, s57, 5
    s_add_u32 s58, s58, s59
    s_add_u32 s58, s58, 1572864
    v_lshl_add_u32 v198, v14, 12, s58
    v_add_u32 v198, v198, v37
    s_and_b32 s58, s30, 1
    s_lshl_b32 s58, s58, 11
    v_lshl_add_u32 v38, v14, 7, s58
    v_xor_b32 v198, v198, v38
    v_lshl_add_u32 v36, v2, 10, v35
    s_lshl_b32 s62, s30, 8
    v_add_u32 v36, s62, v36
    s_lshl_b32 s58, s28, 19
    s_lshl_b32 s59, s57, 15
    s_add_u32 s58, s58, s59
    s_lshl_b32 s59, s91, 12
    s_add_u32 s58, s58, s59
    v_add_u32 v13, s58, v36
    s_lshl_b32 s58, s74, 9
    s_lshl_b32 s59, s57, 14
    s_add_u32 s58, s58, s59
    s_add_u32 s58, s58, 4096
    v_add_u32 v197, s58, v36
    s_mov_b64 s[86:87], -1
    s_movk_i32 s61, 4096
    s_movk_i32 s90, 0x7000
    s_mov_b32 s76, s12
    s_mov_b32 s77, s13
    v_lshl_add_u32 v199, v14, 4, s79
    v_mov_b32 v201, 0
    v_cmp_gt_u32 vcc, 32, v1
    v_add_u32 v36, s75, v41
    v_add_u32 v37, 260096, v36
    v_cmp_gt_u32 s[66:67], 16, v1
    s_sub_u32 s58, s79, 4096
    v_add_u32 v38, s58, v41
    v_cndmask_b32 v36, v37, v36, s[66:67]
    v_cndmask_b32 v204, v38, v36, vcc
    v_add_u32 v36, s70, v41
    s_sub_u32 s58, s73, 4096
    v_add_u32 v37, s58, v41
    v_cndmask_b32 v203, v37, v36, vcc
    s_mov_b32 s84, -1
    s_mov_b32 s85, 15
L_setD:
    s_lshl_b32 s88, s68, 2
    s_sub_u32 s88, 32, s88
    s_cmp_eq_u32 s30, 0
    s_cselect_b32 s84, s84, 1
    s_cselect_b32 s85, s85, 0
    s_mov_b32 s60, 0xffff0000
    s_mov_b32 s43, 0
    v_mov_b32 v8, 0x3ff
    v_mov_b32 v9, 0xff
    v_and_b32 v34, 8, v1
    v_cmp_ne_u32 s[64:65], 0, v34
    v_and_b32 v42, 1, v1
    v_lshlrev_b32 v42, 4, v42
    v_mov_b32 v43, 0xffff
    v_lshlrev_b32 v42, v42, v43
    v_bfe_u32 v43, v1, 1, 2
    v_cmp_eq_u32 vcc, 0, v43
    s_nop 1
    v_cndmask_b32 v4, 0, v42, vcc
    v_cmp_eq_u32 vcc, 1, v43
    s_nop 1
    v_cndmask_b32 v5, 0, v42, vcc
    v_cmp_eq_u32 vcc, 2, v43
    s_nop 1
    v_cndmask_b32 v6, 0, v42, vcc
    v_cmp_eq_u32 vcc, 3, v43
    s_nop 1
    v_cndmask_b32 v7, 0, v42, vcc
    v_mov_b32 v34, 66880
    v_mov_b32 v36, 0
    v_mov_b32 v37, 0
    v_mov_b32 v38, 0
    v_mov_b32 v39, 0
    ds_write_b128 v34, v[36:39]
    s_lshl_b32 s58, s28, 13
    s_lshl_b32 s59, s30, 9
    s_add_u32 s58, s58, s59
    s_add_u32 s58, s58, 65536
    v_lshl_add_u32 v11, v30, 12, s58
    v_lshl_add_u32 v11, v31, 4, v11
    v_lshlrev_b32 v12, 2, v31
    v_lshlrev_b32 v48, 3, v30
    v_xor_b32 v48, v48, v14
    v_lshl_add_u32 v48, v48, 4, s31
    v_lshl_add_u32 v48, v31, 8, v48
    v_xor_b32 v49, 16, v48
    v_xor_b32 v50, 32, v48
    v_xor_b32 v51, 48, v48
    v_xor_b32 v52, 64, v48
    v_xor_b32 v53, 80, v48
    v_xor_b32 v54, 96, v48
    v_xor_b32 v55, 112, v48
    s_mul_i32 s58, s30, 320
    s_add_u32 s58, s58, 65536
    v_lshl_add_u32 v15, v31, 3, s58
    s_waitcnt vmcnt(7)
    global_load_lds_dwordx4 v28, s[46:47] offset:-4096 nt
    v_lshl_add_u32 v15, v30, 2, v15
    v_mul_u32_u24 v16, 320, v32
    v_and_b32 v36, 0x3c, v1
    v_lshl_add_u32 v16, v36, 2, v16
    v_add_u32 v16, 65536, v16
    s_lshl_b32 s58, s30, 6
    s_add_u32 s58, s58, 66944
    v_mul_u32_u24 v17, 576, v30
    v_lshl_add_u32 v17, v31, 1, v17
    v_add_u32 v17, s58, v17
    s_lshl_b32 s58, s30, 2
    s_add_u32 s58, s58, 66816
    v_lshl_add_u32 v18, v2, 4, s58
    v_lshlrev_b32 v20, 4, v32
    v_add_u32 v20, 66816, v20
    v_lshl_add_u32 v19, v33, 2, v20
    s_add_u32 s46, s46, 130048
    s_addc_u32 s47, s47, 0
    s_waitcnt vmcnt(7)
    global_load_lds_dwordx4 v28, s[46:47] offset:-3072 nt
    v_and_b32 v36, 1, v2
    v_lshl_add_u32 v36, v36, 2, v33
    s_lshl_b32 s58, s30, 1
    v_xor_b32 v36, s58, v36
    v_lshlrev_b32 v36, 5, v36
    v_lshl_add_u32 v37, v2, 3, v33
    v_lshl_add_u32 v36, v37, 8, v36
    v_lshl_add_u32 v36, v32, 3, v36
    v_add_u32 v21, 32768, v36
    v_xor_b32 v22, 32, v21
    v_mul_u32_u24 v36, 288, v32
    v_lshl_add_u32 v36, v2, 4, v36
    v_add_u32 v36, 66944, v36
    v_add_u32 v37, 0, v36
    v_cmp_eq_u32 vcc, 0, v33
    s_nop 1
    v_cndmask_b32 v104, v34, v37, vcc
    s_add_u32 s46, s46, 130048
    s_addc_u32 s47, s47, 0
    s_waitcnt vmcnt(7)
    global_load_lds_dwordx4 v29, s[46:47] offset:-2048 nt
    v_add_u32 v37, 64, v36
    v_cmp_eq_u32 vcc, 1, v33
    s_nop 1
    v_cndmask_b32 v105, v34, v37, vcc
    v_add_u32 v37, 128, v36
    v_cmp_eq_u32 vcc, 2, v33
    s_nop 1
    v_cndmask_b32 v106, v34, v37, vcc
    v_add_u32 v37, 192, v36
    v_cmp_eq_u32 vcc, 3, v33
    s_nop 1
    v_cndmask_b32 v107, v34, v37, vcc
    v_mov_b32 v56, 0x3f803f80
    v_mov_b32 v57, v56
    v_mov_b32 v58, v56
    v_mov_b32 v59, v56
    v_and_b32 v36, 4, v1
    v_lshlrev_b32 v36, 4, v36
    v_lshl_add_u32 v36, v32, 14, v36
    s_add_u32 s46, s46, 130048
    s_addc_u32 s47, s47, 0
    s_waitcnt vmcnt(7)
    global_load_lds_dwordx4 v29, s[46:47] offset:-1024 nt
    v_lshl_add_u32 v36, v2, 4, v36
    s_lshl_b32 s58, s30, 12
    s_lshl_b32 s59, s29, 7
    s_add_u32 s59, s59, s58
    s_add_u32 s59, s59, s69
    s_add_u32 s59, s59, 262144
    v_add_u32 v36, s59, v36
    s_lshl_b32 s58, s30, 8
    v_lshl_add_u32 v37, v32, 10, s58
    v_xor_b32 v36, v36, v37
    s_lshl_b32 s62, s29, 4
    s_add_u32 s62, s62, s78
    v_lshl_add_u32 v37, v32, 9, s62
    v_cndmask_b32 v192, v36, v37, s[64:65]
    s_mov_b32 s80, 0x00ff00ff
    s_mov_b32 s81, s80
    s_add_u32 s46, s46, 130048
    s_addc_u32 s47, s47, 0
    s_waitcnt vmcnt(7)
    global_load_lds_dwordx4 v28, s[46:47] offset:0 nt
    s_cmp_eq_u32 s30, 0
    s_cselect_b32 s80, 0x00ff0fff, s80
    s_waitcnt lgkmcnt(0)
    s_add_u32 s32, s32, 1
    s_addc_u32 s33, s33, 0
    s_getreg_b32 s3, hwreg(HW_REG_XCC_ID, 0, 4)
    s_lshl_b32 s59, s3, 28
    s_and_b32 s3, s32, 0x0fffffff
    s_or_b32 s3, s3, s59
    s_lshl_b32 s59, s28, 7
    s_add_u32 s59, s59, 4096
    s_add_u32 s48, s26, s59
    s_addc_u32 s49, s27, 0
    s_and_b32 s63, s32, 1
    s_lshr_b64 s[58:59], s[32:33], 27
    s_and_b32 s34, s32, 0x3fe
    s_add_u32 s46, s46, 130048
    s_addc_u32 s47, s47, 0
    s_waitcnt vmcnt(7)
    global_load_lds_dwordx4 v28, s[46:47] offset:1024 nt
    s_or_b32 s34, s34, s63
    s_xor_b32 s50, s34, 0x2aa
    s_lshr_b32 s35, s32, 9
    s_and_b32 s35, s35, 0x3fe
    s_or_b32 s35, s35, s63
    s_xor_b32 s51, s35, 0x2aa
    s_lshr_b32 s36, s32, 18
    s_and_b32 s36, s36, 0x3fe
    s_or_b32 s36, s36, s63
    s_xor_b32 s52, s36, 0x2aa
    s_and_b32 s37, s58, 0x3fe
    s_or_b32 s37, s37, s63
    s_xor_b32 s53, s37, 0x2aa
    s_and_b32 s38, s32, 0xfe
    s_or_b32 s38, s38, s63
    s_lshr_b32 s39, s32, 7
    s_add_u32 s46, s46, 130048
    s_addc_u32 s47, s47, 0
    s_waitcnt vmcnt(7)
    global_load_lds_dwordx4 v29, s[46:47] offset:2048 nt
    s_and_b32 s39, s39, 0xfe
    s_or_b32 s39, s39, s63
    s_lshr_b32 s40, s32, 14
    s_and_b32 s40, s40, 0xfe
    s_or_b32 s40, s40, s63
    s_lshr_b32 s41, s32, 21
    s_and_b32 s41, s41, 0xfe
    s_or_b32 s41, s41, s63
    v_mul_u32_u24 v36, 9, v2
    v_lshrrev_b64 v[36:37], v36, s[32:33]
    v_and_b32 v36, 0x3fe, v36
    v_or_b32 v202, s63, v36
    s_add_u32 s46, s46, 130048
    s_addc_u32 s47, s47, 0
    s_waitcnt vmcnt(7)
    global_load_lds_dwordx4 v29, s[46:47] offset:3072 nt
    s_barrier
    global_load_dwordx4 v[24:27], v11, s[26:27] sc1
    global_load_dwordx4 v[32:35], v11, s[26:27] offset:2048 sc1
    global_load_dword v36, v12, s[48:49] sc1
    s_barrier
    s_mov_b64 exec, s[84:85]
    global_load_dword v3, v203, s[26:27] sc1
    s_mov_b64 exec, -1
    global_load_dword v108, v201, s[4:5]
    s_waitcnt vmcnt(13)
    ds_read_b128 v[72:75], v48
    ds_read_b128 v[76:79], v49
    ds_read_b128 v[80:83], v50
    ds_read_b128 v[84:87], v51
    ds_read_b128 v[88:91], v52
    ds_read_b128 v[92:95], v53
    ds_read_b128 v[96:99], v54
    ds_read_b128 v[100:103], v55
    s_mov_b64 exec, s[86:87]
    global_load_dwordx4 v[160:163], v13, s[76:77] nt
    v_add_u32 v23, s61, v13
    v_bfi_b32 v13, s90, v23, v13
    global_load_dwordx4 v[164:167], v13, s[76:77] nt
    v_add_u32 v23, s61, v13
    v_bfi_b32 v13, s90, v23, v13
    s_mov_b64 exec, -1
    s_cmp_lt_u32 s29, 16
    s_cbranch_scc1 L_gq
    s_mov_b64 exec, s[86:87]
    global_load_dwordx4 v[168:171], v13, s[76:77] nt
    v_add_u32 v23, s61, v13
    v_bfi_b32 v13, s90, v23, v13
    global_load_dwordx4 v[172:175], v13, s[76:77] nt
    v_add_u32 v23, s61, v13
    v_bfi_b32 v13, s90, v23, v13
    global_load_dwordx4 v[176:179], v13, s[76:77] nt
    v_add_u32 v23, s61, v13
    v_bfi_b32 v13, s90, v23, v13
    global_load_dwordx4 v[180:183], v13, s[76:77] nt
    v_add_u32 v23, s61, v13
    v_bfi_b32 v13, s90, v23, v13
    global_load_dwordx4 v[184:187], v13, s[76:77] nt
    v_add_u32 v23, s61, v13
    v_bfi_b32 v13, s90, v23, v13
    s_mov_b64 exec, -1
    s_waitcnt vmcnt(9)
    s_branch L_qchk
L_gq:
    s_waitcnt vmcnt(4)
L_qchk:
    v_xor_b32 v24, s38, v24
    v_xor_b32 v25, s39, v25
    v_xor_b32 v26, s40, v26
    v_xor_b32 v27, s41, v27
    v_xor_b32 v32, s38, v32
    v_xor_b32 v33, s39, v33
    v_xor_b32 v34, s40, v34
    v_xor_b32 v35, s41, v35
    v_add_f32 v28, v24, v32
    v_add_f32 v30, v26, v34
    v_add_f32 v29, v25, v33
    v_add_f32 v31, v27, v35
    v_or3_b32 v37, v24, v25, v26
    v_permlane32_swap_b32 v28, v30
    v_permlane32_swap_b32 v29, v31
    v_add_f32 v28, v28, v30
    v_add_f32 v29, v29, v31
    v_cvt_pk_bf16_f32 v28, v28, v29
    ds_write_b32 v15, v28
    v_xor_b32 v36, s3, v36
    v_lshlrev_b32 v38, 4, v36
    v_cmp_ne_u32 s[82:83], 0, v36
    v_cmp_ne_u32 s[66:67], 0, v38
    v_or3_b32 v37, v27, v32, v37
    v_or3_b32 v37, v33, v34, v37
    v_bitop3_b32 v37, v35, v37, v9 bitop3:0xa8
    v_cmp_ne_u32 vcc, 0, v37
    s_or_b32 s42, s82, s83
    s_or_b64 vcc, vcc, s[66:67]
    s_cbranch_vccnz L_q_retry
    s_cmp_lt_u32 s29, 16
    s_cbranch_scc1 L_now0
    s_mov_b64 exec, s[86:87]
    global_load_dwordx4 v[188:191], v13, s[76:77] nt
    s_mov_b64 exec, -1
L_now0:
    s_waitcnt lgkmcnt(0)
    s_barrier
    ds_read_b128 v[24:27], v16
    ds_read_b64_tr_b16 v[128:129], v21 offset:0
    ds_read_b64_tr_b16 v[130:131], v21 offset:1024
    ds_read_b64_tr_b16 v[132:133], v21 offset:8192
    ds_read_b64_tr_b16 v[134:135], v21 offset:9216
    ds_read_b64_tr_b16 v[136:137], v21 offset:16384
    ds_read_b64_tr_b16 v[138:139], v21 offset:17408
    ds_read_b64_tr_b16 v[140:141], v21 offset:24576
    ds_read_b64_tr_b16 v[142:143], v21 offset:25600
    s_waitcnt lgkmcnt(8)
    v_mfma_f32_4x4x4_16b_bf16 v[28:31], v[24:25], v[72:73], 0 cbsz:3 abid:0
    v_mfma_f32_4x4x4_16b_bf16 v[32:35], v[26:27], v[74:75], 0 cbsz:3 abid:0
    ds_read_b64_tr_b16 v[144:145], v22 offset:0
    v_mfma_f32_4x4x4_16b_bf16 v[28:31], v[24:25], v[76:77], v[28:31] cbsz:3 abid:1
    v_mfma_f32_4x4x4_16b_bf16 v[32:35], v[26:27], v[78:79], v[32:35] cbsz:3 abid:1
    ds_read_b64_tr_b16 v[146:147], v22 offset:1024
    v_mfma_f32_4x4x4_16b_bf16 v[28:31], v[24:25], v[80:81], v[28:31] cbsz:3 abid:2
    v_mfma_f32_4x4x4_16b_bf16 v[32:35], v[26:27], v[82:83], v[32:35] cbsz:3 abid:2
    ds_read_b64_tr_b16 v[148:149], v22 offset:8192
    v_mfma_f32_4x4x4_16b_bf16 v[28:31], v[24:25], v[84:85], v[28:31] cbsz:3 abid:3
    v_mfma_f32_4x4x4_16b_bf16 v[32:35], v[26:27], v[86:87], v[32:35] cbsz:3 abid:3
    ds_read_b64_tr_b16 v[150:151], v22 offset:9216
    v_mfma_f32_4x4x4_16b_bf16 v[28:31], v[24:25], v[88:89], v[28:31] cbsz:3 abid:4
    v_mfma_f32_4x4x4_16b_bf16 v[32:35], v[26:27], v[90:91], v[32:35] cbsz:3 abid:4
    ds_read_b64_tr_b16 v[152:153], v22 offset:16384
    v_mfma_f32_4x4x4_16b_bf16 v[28:31], v[24:25], v[92:93], v[28:31] cbsz:3 abid:5
    v_mfma_f32_4x4x4_16b_bf16 v[32:35], v[26:27], v[94:95], v[32:35] cbsz:3 abid:5
    ds_read_b64_tr_b16 v[154:155], v22 offset:17408
    v_mfma_f32_4x4x4_16b_bf16 v[28:31], v[24:25], v[96:97], v[28:31] cbsz:3 abid:6
    v_mfma_f32_4x4x4_16b_bf16 v[32:35], v[26:27], v[98:99], v[32:35] cbsz:3 abid:6
    ds_read_b64_tr_b16 v[156:157], v22 offset:24576
    v_mfma_f32_4x4x4_16b_bf16 v[28:31], v[24:25], v[100:101], v[28:31] cbsz:3 abid:7
    v_mfma_f32_4x4x4_16b_bf16 v[32:35], v[26:27], v[102:103], v[32:35] cbsz:3 abid:7
    ds_read_b64_tr_b16 v[158:159], v22 offset:25600
    s_nop 3
    v_add_f32 v28, v28, v32
    v_add_f32 v30, v30, v34
    v_add_f32 v29, v29, v33
    v_add_f32 v31, v31, v35
    v_permlane32_swap_b32 v28, v30
    s_nop 0
    v_permlane32_swap_b32 v29, v31
    v_add_f32 v28, v28, v30
    v_add_f32_e64 v29, v29, v31
    v_cvt_pk_bf16_f32 v28, 0, v28
    v_cvt_pk_bf16_f32 v29, 0, v29
    v_mul_f32 v28, 0x3db504f3, v28
    v_mul_f32 v29, 0x3db504f3, v29
    v_cvt_pk_bf16_f32 v28, 0, v28
    v_cvt_pk_bf16_f32 v29, 0, v29
    v_mul_f32 v36, 0x3fb8aa3b, v28
    v_max_f32_dpp v30, v28, v28 quad_perm:[1,0,3,2] row_mask:0xf bank_mask:0xf
    v_max_f32_dpp v31, v29, v29 quad_perm:[1,0,3,2] row_mask:0xf bank_mask:0xf
    v_mul_f32 v37, 0x3fb8aa3b, v29
    v_max_f32_dpp v30, v30, v30 quad_perm:[2,3,0,1] row_mask:0xf bank_mask:0xf
    v_max_f32_dpp v31, v31, v31 quad_perm:[2,3,0,1] row_mask:0xf bank_mask:0xf
    s_nop 0
    v_max_f32_dpp v30, v30, v30 row_half_mirror row_mask:0xf bank_mask:0xf
    v_max_f32_dpp v31, v31, v31 row_half_mirror row_mask:0xf bank_mask:0xf
    s_nop 0
    v_max_f32_dpp v30, v30, v30 row_mirror row_mask:0xf bank_mask:0xf
    v_max_f32_dpp v31, v31, v31 row_mirror row_mask:0xf bank_mask:0xf
    s_nop 1
    v_permlane16_swap_b32 v30, v31
    v_max_f32 v32, v30, v31
    v_max_f32 v33, v30, v31
    v_max_f32 v34, v30, v31
    s_mov_b32 s92, 0x10001
    v_permlane16_swap_b32 v32, v33
    v_fmac_f32 v36, 0xbfb8aa3b, v32
    v_fmac_f32 v37, 0xbfb8aa3b, v33
    v_exp_f32 v36, v36
    v_exp_f32 v37, v37
    s_mov_b32 s93, s92
    v_cvt_pk_bf16_f32 v30, v36, v37
    ds_write_b16 v17, v30
    ds_write_b16_d16_hi v17, v30 offset:288
    s_mov_b64 exec, s[92:93]
    ds_write_b32 v18, v34
    s_mov_b64 exec, -1
    s_waitcnt lgkmcnt(0)
    s_barrier
    ds_read_b128 v[24:27], v104
    ds_read_b128 v[28:31], v105
    ds_read_b128 v[32:35], v106
    ds_read_b128 v[36:39], v107
    ds_read_b128 v[40:43], v20
    ds_read_b32 v44, v19
    s_cmp_lg_u32 s42, 0
    s_waitcnt lgkmcnt(5)
    v_mfma_f32_16x16x32_bf16 v[60:63], v[128:131], v[24:27], 0
    s_waitcnt lgkmcnt(4)
    v_mfma_f32_16x16x32_bf16 v[60:63], v[132:135], v[28:31], v[60:63]
    s_waitcnt lgkmcnt(3)
    v_mfma_f32_16x16x32_bf16 v[60:63], v[136:139], v[32:35], v[60:63]
    s_waitcnt lgkmcnt(2)
    v_mfma_f32_16x16x32_bf16 v[60:63], v[140:143], v[36:39], v[60:63]
    s_waitcnt lgkmcnt(0)
    v_mfma_f32_16x16x32_bf16 v[64:67], v[144:147], v[24:27], 0
    v_max3_f32 v40, v40, v41, v42
    v_max_f32 v40, v40, v43
    v_mfma_f32_16x16x32_bf16 v[64:67], v[148:151], v[28:31], v[64:67]
    v_sub_f32 v44, v44, v40
    v_mul_f32 v44, 0x3fb8aa3b, v44
    v_mfma_f32_16x16x32_bf16 v[64:67], v[152:155], v[32:35], v[64:67]
    v_exp_f32 v44, v44
    v_mfma_f32_16x16x32_bf16 v[64:67], v[156:159], v[36:39], v[64:67]
    v_mfma_f32_16x16x32_bf16 v[68:71], v[56:59], v[24:27], 0
    v_mul_f32 v60, v60, v44
    v_mul_f32 v61, v61, v44
    v_mfma_f32_16x16x32_bf16 v[68:71], v[56:59], v[28:31], v[68:71]
    v_mul_f32 v62, v62, v44
    v_mul_f32 v63, v63, v44
    v_mfma_f32_16x16x32_bf16 v[68:71], v[56:59], v[32:35], v[68:71]
    v_add_f32_dpp v45, v60, v60 row_ror:4 row_mask:0xf bank_mask:0x5
    v_add_f32_dpp v46, v61, v61 row_ror:4 row_mask:0xf bank_mask:0x5
    v_mfma_f32_16x16x32_bf16 v[68:71], v[56:59], v[36:39], v[68:71]
    v_add_f32_dpp v47, v62, v62 row_ror:4 row_mask:0xf bank_mask:0x5
    v_add_f32_dpp v48, v63, v63 row_ror:4 row_mask:0xf bank_mask:0x5
    v_mul_f32 v64, v64, v44
    v_mul_f32 v65, v65, v44
    v_mul_f32 v66, v66, v44
    v_mul_f32 v67, v67, v44
    v_add_f32_dpp v45, v64, v64 row_ror:4 row_mask:0xf bank_mask:0xa
    v_add_f32_dpp v46, v65, v65 row_ror:4 row_mask:0xf bank_mask:0xa
    v_add_f32_dpp v47, v66, v66 row_ror:4 row_mask:0xf bank_mask:0xa
    v_add_f32_dpp v48, v67, v67 row_ror:4 row_mask:0xf bank_mask:0xa
    v_mul_f32 v68, v68, v44
    v_mov_b32 v60, v40
    v_mov_b32_e64 v62, v40
    v_add_f32_dpp v68, v68, v68 row_ror:4 row_mask:0xf bank_mask:0xf
    v_add_f32_dpp v60, v45, v45 row_ror:8 row_mask:0xf bank_mask:0x3
    v_add_f32_dpp v62, v47, v47 row_ror:8 row_mask:0xf bank_mask:0x3
    v_add_f32_dpp v61, v68, v68 row_ror:8 row_mask:0xf bank_mask:0x4
    v_add_f32_dpp v63, v68, v68 row_ror:8 row_mask:0xf bank_mask:0x4
    v_bfi_b32 v60, v8, s34, v60
    v_add_f32_dpp v61, v46, v46 row_ror:8 row_mask:0xf bank_mask:0x3
    v_add_f32_dpp v63, v48, v48 row_ror:8 row_mask:0xf bank_mask:0x3
    s_mov_b64 exec, s[80:81]
    v_bfi_b32 v62, v8, s36, v62
    v_bfi_b32 v61, v8, s35, v61
    v_bfi_b32 v63, v8, s37, v63
    s_cbranch_scc1 L_slow1
    global_store_dwordx4 v192, v[60:63], s[26:27] nt
L_back1:
    s_mov_b64 exec, -1
    s_cmp_ge_u32 s29, 16
    s_cbranch_scc1 L_R
    s_barrier
    s_mov_b64 exec, s[86:87]
    global_load_dwordx4 v[168:171], v13, s[76:77] nt
    v_add_u32 v23, s61, v13
    v_bfi_b32 v13, s90, v23, v13
    global_load_dwordx4 v[172:175], v13, s[76:77] nt
    v_add_u32 v23, s61, v13
    v_bfi_b32 v13, s90, v23, v13
    global_load_dwordx4 v[176:179], v13, s[76:77] nt
    v_add_u32 v23, s61, v13
    v_bfi_b32 v13, s90, v23, v13
    global_load_dwordx4 v[180:183], v13, s[76:77] nt
    v_add_u32 v23, s61, v13
    v_bfi_b32 v13, s90, v23, v13
    global_load_dwordx4 v[184:187], v13, s[76:77] nt
    v_add_u32 v23, s61, v13
    v_bfi_b32 v13, s90, v23, v13
    global_load_dwordx4 v[188:191], v13, s[76:77] nt
    s_mov_b64 exec, -1
    v_and_b32 v56, v56, v4
    v_and_b32 v57, v57, v5
    v_and_b32 v58, v58, v6
    v_and_b32 v59, v59, v7
    s_waitcnt vmcnt(0)
    v_lshlrev_b32 v206, 16, v108
    v_and_b32 v207, s60, v108
    s_cmp_lg_u32 s30, 0
    s_cbranch_scc1 L_nored
L_h3a_poll:
    global_load_dwordx4 v[72:75], v195, s[26:27] offset:0 sc1
    global_load_dwordx4 v[76:79], v193, s[26:27] offset:0 sc1
    s_add_u32 s43, s43, 1
    s_cmp_gt_u32 s43, 200000
    s_cbranch_scc1 L_end
    s_waitcnt vmcnt(0)
    v_xor_b32 v72, s50, v72
    v_xor_b32 v76, s50, v76
    v_bitop3_b32 v36, v72, v76, v8 bitop3:0xa8
    v_cmp_ne_u32 vcc, 0, v36
    v_xor_b32 v73, s51, v73
    s_cbranch_vccnz L_h3a_poll
    v_xor_b32 v74, s52, v74
    v_xor_b32 v75, s53, v75
    v_xor_b32 v77, s51, v77
    v_xor_b32 v78, s52, v78
    v_xor_b32 v79, s53, v79
    v_add_f32 v80, v72, v76
    v_add_f32 v82, v74, v78
    v_add_f32 v81, v73, v77
    v_add_f32 v83, v75, v79
    v_or3_b32 v36, v73, v74, v75
    v_permlane32_swap_b32 v80, v82
    v_permlane32_swap_b32 v81, v83
    v_add_f32 v80, v80, v82
    v_add_f32 v81, v81, v83
    v_or3_b32 v36, v77, v78, v36
    v_bitop3_b32 v36, v79, v36, v8 bitop3:0xa8
    v_permlane16_swap_b32 v80, v81
    v_add_f32 v80, v80, v81
    v_cmp_ne_u32 vcc, 0, v36
    s_nop 0
    v_add_f32_dpp v80, v80, v80 row_ror:8 row_mask:0xf bank_mask:0xf
    s_cbranch_vccnz L_h3a_poll
    s_mov_b32 exec_lo, 0xff00ff
    s_mov_b32 exec_hi, 0xff00ff
    v_bfi_b32 v80, v8, v202, v80
    global_store_dword v197, v80, s[26:27] sc1
    s_mov_b64 exec, -1
L_nored:
    s_barrier
    global_load_dwordx4 v[24:27], v196, s[26:27] sc1
    v_mfma_f32_16x16x32_bf16 v[60:63], v[56:59], v[160:163], 0
    v_mfma_f32_16x16x32_bf16 v[60:63], v[56:59], v[164:167], v[60:63]
    v_mfma_f32_16x16x32_bf16 v[60:63], v[56:59], v[168:171], v[60:63]
    v_mfma_f32_16x16x32_bf16 v[60:63], v[56:59], v[172:175], v[60:63]
    v_mfma_f32_16x16x32_bf16 v[60:63], v[56:59], v[176:179], v[60:63]
    v_mfma_f32_16x16x32_bf16 v[60:63], v[56:59], v[180:183], v[60:63]
    v_mfma_f32_16x16x32_bf16 v[60:63], v[56:59], v[184:187], v[60:63]
    v_mfma_f32_16x16x32_bf16 v[60:63], v[56:59], v[188:191], v[60:63]
    s_cmp_lg_u32 s42, 0
    s_mov_b32 exec_lo, s86
    s_mov_b32 exec_hi, 0
    s_nop 4
    v_bfi_b32 v60, v8, s50, v60
    v_bfi_b32 v61, v8, s51, v61
    v_bfi_b32 v62, v8, s52, v62
    v_bfi_b32 v63, v8, s53, v63
    s_cbranch_scc1 L_slow2
    global_store_dwordx4 v204, v[60:63], s[26:27] nt
L_back2:
    s_mov_b64 exec, -1
    s_waitcnt vmcnt(1)
    s_branch L_d1_chk
L_d1_poll:
    global_load_dwordx4 v[24:27], v196, s[26:27] sc1
    s_add_u32 s43, s43, 1
    s_cmp_gt_u32 s43, 200000
    s_cbranch_scc1 L_end
    s_waitcnt vmcnt(0)
L_d1_chk:
    v_xor_b32 v24, s34, v24
    v_xor_b32 v25, s35, v25
    v_xor_b32 v26, s36, v26
    v_xor_b32 v27, s37, v27
    v_or3_b32 v36, v24, v25, v26
    v_bitop3_b32 v36, v27, v36, v8 bitop3:0xa8
    v_cmp_ne_u32 vcc, 0, v36
    s_cbranch_vccnz L_d1_poll
    v_add_f32_dpp v28, v24, v24 row_half_mirror row_mask:0xf bank_mask:0x5
    v_add_f32_dpp v29, v25, v25 row_half_mirror row_mask:0xf bank_mask:0x5
    s_nop 0
    v_add_f32_dpp v28, v26, v26 row_half_mirror row_mask:0xf bank_mask:0xa
    v_add_f32_dpp v29, v27, v27 row_half_mirror row_mask:0xf bank_mask:0xa
    s_nop 0
    v_add_f32_dpp v28, v28, v28 quad_perm:[1,0,3,2] row_mask:0xf bank_mask:0xf
    v_add_f32_dpp v29, v29, v29 quad_perm:[1,0,3,2] row_mask:0xf bank_mask:0xf
    s_nop 0
    v_add_f32_dpp v28, v28, v28 quad_perm:[2,3,0,1] row_mask:0xf bank_mask:0xf
    v_add_f32_dpp v29, v29, v29 quad_perm:[2,3,0,1] row_mask:0xf bank_mask:0xf
    v_cvt_pk_bf16_f32 v28, 0, v28
    v_cvt_pk_bf16_f32 v29, 0, v29
    v_add_f32 v28, v28, v206
    v_add_f32 v29, v29, v207
    v_cvt_pk_bf16_f32 v28, v28, v28
    v_cvt_pk_bf16_f32 v29, v29, v29
    s_cmp_lg_u32 s42, 0
    v_and_b32_dpp v72, v28, v4 row_newbcast:0 row_mask:0xf bank_mask:0xf
    v_and_b32_dpp v73, v28, v5 row_newbcast:0 row_mask:0xf bank_mask:0xf
    v_and_b32_dpp v74, v28, v6 row_newbcast:0 row_mask:0xf bank_mask:0xf
    v_and_b32_dpp v75, v28, v7 row_newbcast:0 row_mask:0xf bank_mask:0xf
    v_and_b32_dpp v76, v29, v4 row_newbcast:0 row_mask:0xf bank_mask:0xf
    v_and_b32_dpp v77, v29, v5 row_newbcast:0 row_mask:0xf bank_mask:0xf
    v_and_b32_dpp v78, v29, v6 row_newbcast:0 row_mask:0xf bank_mask:0xf
    v_and_b32_dpp v79, v29, v7 row_newbcast:0 row_mask:0xf bank_mask:0xf
    v_mfma_f32_16x16x32_bf16 v[60:63], v[72:75], v[160:163], 0
    v_and_b32_dpp v80, v28, v4 row_newbcast:4 row_mask:0xf bank_mask:0xf
    v_and_b32_dpp v81, v28, v5 row_newbcast:4 row_mask:0xf bank_mask:0xf
    v_and_b32_dpp v82, v28, v6 row_newbcast:4 row_mask:0xf bank_mask:0xf
    v_and_b32_dpp v83, v28, v7 row_newbcast:4 row_mask:0xf bank_mask:0xf
    v_mfma_f32_16x16x32_bf16 v[60:63], v[76:79], v[164:167], v[60:63]
    v_and_b32_dpp v84, v29, v4 row_newbcast:4 row_mask:0xf bank_mask:0xf
    v_and_b32_dpp v85, v29, v5 row_newbcast:4 row_mask:0xf bank_mask:0xf
    v_and_b32_dpp v86, v29, v6 row_newbcast:4 row_mask:0xf bank_mask:0xf
    v_and_b32_dpp v87, v29, v7 row_newbcast:4 row_mask:0xf bank_mask:0xf
    v_mfma_f32_16x16x32_bf16 v[60:63], v[80:83], v[168:171], v[60:63]
    v_and_b32_dpp v72, v28, v4 row_newbcast:8 row_mask:0xf bank_mask:0xf
    v_and_b32_dpp v73, v28, v5 row_newbcast:8 row_mask:0xf bank_mask:0xf
    v_and_b32_dpp v74, v28, v6 row_newbcast:8 row_mask:0xf bank_mask:0xf
    v_and_b32_dpp v75, v28, v7 row_newbcast:8 row_mask:0xf bank_mask:0xf
    v_mfma_f32_16x16x32_bf16 v[60:63], v[84:87], v[172:175], v[60:63]
    v_and_b32_dpp v76, v29, v4 row_newbcast:8 row_mask:0xf bank_mask:0xf
    v_and_b32_dpp v77, v29, v5 row_newbcast:8 row_mask:0xf bank_mask:0xf
    v_and_b32_dpp v78, v29, v6 row_newbcast:8 row_mask:0xf bank_mask:0xf
    v_and_b32_dpp v79, v29, v7 row_newbcast:8 row_mask:0xf bank_mask:0xf
    v_mfma_f32_16x16x32_bf16 v[60:63], v[72:75], v[176:179], v[60:63]
    v_and_b32_dpp v80, v28, v4 row_newbcast:12 row_mask:0xf bank_mask:0xf
    v_and_b32_dpp v81, v28, v5 row_newbcast:12 row_mask:0xf bank_mask:0xf
    v_and_b32_dpp v82, v28, v6 row_newbcast:12 row_mask:0xf bank_mask:0xf
    v_and_b32_dpp v83, v28, v7 row_newbcast:12 row_mask:0xf bank_mask:0xf
    v_mfma_f32_16x16x32_bf16 v[60:63], v[76:79], v[180:183], v[60:63]
    v_and_b32_dpp v84, v29, v4 row_newbcast:12 row_mask:0xf bank_mask:0xf
    v_and_b32_dpp v85, v29, v5 row_newbcast:12 row_mask:0xf bank_mask:0xf
    v_and_b32_dpp v86, v29, v6 row_newbcast:12 row_mask:0xf bank_mask:0xf
    v_and_b32_dpp v87, v29, v7 row_newbcast:12 row_mask:0xf bank_mask:0xf
    v_mfma_f32_16x16x32_bf16 v[60:63], v[80:83], v[184:187], v[60:63]
    v_and_b32 v100, s60, v28
    v_and_b32 v101, s60, v29
    v_mfma_f32_16x16x32_bf16 v[60:63], v[84:87], v[188:191], v[60:63]
    v_readfirstlane_b32 s58, v100
    s_mov_b32 s92, s86
    s_mov_b32 s93, 0
    v_subrev_f32 v24, s58, v100
    v_subrev_f32 v25, s58, v101
    v_mul_f32 v33, v24, v24
    v_add_f32 v32, v24, v25
    v_fmac_f32 v33, v25, v25
    s_mov_b64 exec, s[92:93]
    v_bfi_b32 v60, v8, s34, v60
    v_bfi_b32 v61, v8, s35, v61
    v_bfi_b32 v62, v8, s36, v62
    v_bfi_b32 v63, v8, s37, v63
    s_cbranch_scc1 L_slow3
    global_store_dwordx4 v198, v[60:63], s[26:27] nt
L_back3:
    s_mov_b64 exec, -1
    s_cmp_lg_u32 s30, 3
    s_cbranch_scc1 L_nostat
    v_add_f32_dpp v32, v32, v32 row_ror:4 row_mask:0xf bank_mask:0xf
    v_add_f32_dpp v33, v33, v33 row_ror:4 row_mask:0xf bank_mask:0xf
    s_cmp_lg_u32 s42, 0
    v_add_f32_dpp v32, v32, v32 row_ror:8 row_mask:0xf bank_mask:0xf
    v_add_f32_dpp v33, v33, v33 row_ror:8 row_mask:0xf bank_mask:0xf
    s_nop 0
    v_add_f32_dpp v32, v32, v32 row_bcast:15 row_mask:0xa bank_mask:0xf
    v_add_f32_dpp v33, v33, v33 row_bcast:15 row_mask:0xa bank_mask:0xf
    s_nop 0
    v_add_f32_dpp v32, v32, v32 row_bcast:31 row_mask:0xc bank_mask:0xf
    v_add_f32_dpp v33, v33, v33 row_bcast:31 row_mask:0xc bank_mask:0xf
    s_mov_b32 exec_lo, 0x0
    s_mov_b32 exec_hi, 0x80000000
    v_mul_f32 v34, 0x3d000000, v32
    v_fma_f32 v33, -v34, v32, v33
    v_add_f32_e64 v32, s58, v34
    v_bfi_b32 v35, v8, s37, v33
    v_bfi_b32 v33, v8, s35, v33
    v_bfi_b32 v34, v8, s36, v32
    v_bfi_b32 v32, v8, s34, v32
    s_cbranch_scc1 L_slow4
    global_store_dwordx4 v199, v[32:35], s[26:27] nt
L_back4:
    s_mov_b64 exec, -1
L_nostat:
    s_lshr_b32 s58, s28, 2
    s_xor_b32 s58, s58, s29
    s_and_b32 s58, s58, 1
    s_or_b32 s58, s58, s30
    s_cbranch_scc1 L_fin
    v_and_b32 v111, 12, v1
    v_lshlrev_b32 v111, 1, v111
    v_lshl_add_u32 v111, v2, 5, v111
    v_add_u32 v111, 65536, v111
    s_and_b32 s58, s28, 3
    s_lshl_b32 s59, s58, 3
    v_and_b32 v41, 1, v1
    v_lshl_add_u32 v41, v41, 2, v2
    v_add_u32 v41, s59, v41
    v_lshlrev_b32 v112, 2, v41
    v_add_u32 v112, 65536, v112
    s_lshl_b32 s59, s57, 6
    v_lshl_add_u32 v41, v41, 1, s59
    s_lshl_b32 s59, s57, 2
    s_add_u32 s58, s58, s59
    s_and_b32 s59, s58, 7
    s_lshl_b32 s59, s59, 7
    s_lshl_b32 s58, s58, 12
    s_add_u32 s58, s58, 1572864
    v_add_u32 v43, s58, v10
    v_xor_b32_e64 v43, s59, v43
    s_lshl_b32 s58, s28, 8
    s_add_u32 s58, s58, 180224
    v_lshl_add_u32 v44, v1, 2, s58
    s_mov_b32 exec_lo, 0x11111111
    s_mov_b32 exec_hi, 0x11111111
    ds_write_b64 v111, v[100:101]
    s_mov_b64 exec, -1
    s_waitcnt lgkmcnt(0)
    ds_read_b32 v42, v112
    s_cmp_eq_u32 s68, 0
    v_mov_b32 v72, 0
    v_mov_b32 v73, 0
    v_mov_b32 v74, 0
    v_mov_b32 v75, 0
    v_mov_b32 v76, 0
    v_mov_b32 v77, 0
    v_mov_b32 v78, 0
    v_mov_b32 v79, 0
    v_mov_b32 v80, 0
    v_mov_b32 v81, 0
    v_mov_b32 v82, 0
    v_mov_b32 v83, 0
    v_mov_b32 v84, 0
    v_mov_b32 v85, 0
    v_mov_b32 v86, 0
    v_mov_b32 v87, 0
    s_cselect_b32 exec_hi, -1, 0xffff
    s_waitcnt lgkmcnt(0)
L_hint:
    global_load_dword v45, v44, s[26:27] sc1
    s_add_u32 s43, s43, 1
    s_cmp_gt_u32 s43, 200000
    s_cbranch_scc1 L_end
    s_waitcnt vmcnt(0)
    v_cmp_ne_u32 vcc, s32, v45
    s_cbranch_vccnz L_hint
L_f_poll:
    s_mov_b32 exec_hi, 0x00ffffff
    global_load_dwordx4 v[72:75], v43, s[26:27] offset:0 sc1
    global_load_dwordx4 v[76:79], v43, s[26:27] offset:1024 sc1
    global_load_dwordx4 v[80:83], v43, s[26:27] offset:2048 sc1
    global_load_dwordx4 v[84:87], v43, s[26:27] offset:3072 sc1
    s_add_u32 s43, s43, 1
    s_cmp_gt_u32 s43, 200000
    s_cbranch_scc1 L_end
    s_waitcnt vmcnt(0)
    v_xor_b32 v72, s34, v72
    v_xor_b32 v73, s35, v73
    v_xor_b32 v74, s36, v74
    v_xor_b32 v75, s37, v75
    v_xor_b32 v76, s34, v76
    v_xor_b32 v77, s35, v77
    v_xor_b32 v78, s36, v78
    v_xor_b32 v79, s37, v79
    v_xor_b32 v80, s34, v80
    v_xor_b32 v81, s35, v81
    v_xor_b32 v82, s36, v82
    v_xor_b32 v83, s37, v83
    v_xor_b32 v84, s34, v84
    v_xor_b32 v85, s35, v85
    v_xor_b32 v86, s36, v86
    v_xor_b32 v87, s37, v87
    s_mov_b64 exec, -1
    v_add_f32 v88, v72, v76
    v_add_f32 v92, v80, v84
    v_add_f32 v90, v74, v78
    v_add_f32 v94, v82, v86
    v_add_f32 v89, v73, v77
    v_add_f32 v93, v81, v85
    v_add_f32 v91, v75, v79
    v_add_f32 v95, v83, v87
    v_add_f32 v88, v88, v92
    v_add_f32 v90, v90, v94
    v_add_f32 v89, v89, v93
    v_add_f32 v91, v91, v95
    v_or3_b32 v36, v72, v73, v74
    v_permlane32_swap_b32 v88, v90
    v_permlane32_swap_b32 v89, v91
    v_add_f32 v88, v88, v90
    v_add_f32 v89, v89, v91
    v_or3_b32 v36, v75, v76, v36
    v_or3_b32 v36, v77, v78, v36
    v_permlane16_swap_b32 v88, v89
    v_add_f32_e64 v88, v88, v89
    v_or3_b32 v36, v79, v80, v36
    v_or3_b32 v36, v81, v82, v36
    v_add_f32_dpp v88, v88, v88 row_ror:8 row_mask:0xf bank_mask:0xf
    v_or3_b32 v36, v83, v84, v36
    v_or3_b32 v36, v85, v86, v36
    v_add_f32_dpp v88, v88, v88 row_ror:4 row_mask:0xf bank_mask:0xf
    v_bitop3_b32 v36, v87, v36, v8 bitop3:0xa8
    v_cmp_ne_u32 vcc, 0, v36
    v_add_f32_dpp v88, v88, v88 quad_perm:[2,3,0,1] row_mask:0xf bank_mask:0xf
    v_cvt_pk_bf16_f32 v88, 0, v88
    s_cbranch_vccnz L_f_poll
    s_mov_b32 exec_lo, 0x30003
    s_mov_b32 exec_hi, 0x30003
    v_add_f32 v88, v88, v42
    v_cvt_pk_bf16_f32 v88, v88, v88
    global_store_short v41, v88, s[22:23]
    s_cmp_lg_u32 s2, 127
    s_cbranch_scc1 L_fin0
    s_mov_b64 exec, 1
    v_mov_b32 v74, s32
    v_mov_b32 v75, s33
    v_mov_b32 v76, 0
    global_store_dwordx2 v76, v[74:75], s[26:27]
L_fin0:
L_fin:
    s_endpgm
L_R:
    v_mov_b32 v39, 0xbfb8aa3b
L_h2_poll:
    global_load_dwordx4 v[32:35], v194, s[26:27] sc1
    global_load_dwordx4 v[24:27], v193, s[26:27] sc1
    s_add_u32 s43, s43, 1
    s_cmp_gt_u32 s43, 200000
    s_cbranch_scc1 L_end
    s_waitcnt vmcnt(0)
    v_xor_b32 v32, s34, v32
    v_xor_b32 v24, s34, v24
    v_bitop3_b32 v37, v32, v24, v8 bitop3:0xa8
    v_cmp_ne_u32 vcc, 0, v37
    v_xor_b32 v33, s35, v33
    s_cbranch_vccnz L_h2_poll
    v_xor_b32 v34, s36, v34
    v_xor_b32 v35, s37, v35
    v_xor_b32 v25, s35, v25
    v_xor_b32 v26, s36, v26
    v_xor_b32 v27, s37, v27
    v_max_f32_dpp v36, v32, v32 row_ror:8 row_mask:0xf bank_mask:0xf
    v_or3_b32 v37, v33, v34, v35
    v_or3_b32 v37, v25, v26, v37
    v_max_f32_dpp v36, v36, v36 row_ror:4 row_mask:0xf bank_mask:0xf
    v_bitop3_b32 v37, v27, v37, v8 bitop3:0xa8
    v_cmp_ne_u32 vcc, 0, v37
    v_max_f32_dpp v36, v36, v36 quad_perm:[2,3,0,1] row_mask:0xf bank_mask:0xf
    v_mul_f32 v38, 0x3fb8aa3b, v32
    s_nop 0
    v_max_f32_dpp v36, v36, v36 row_bcast:15 row_mask:0xa bank_mask:0xf
    s_cbranch_vccnz L_h2_poll
    s_cmp_lg_u32 s42, 0
    v_max_f32_dpp v36, v36, v36 row_bcast:31 row_mask:0xc bank_mask:0xf
    s_nop 0
    v_readlane_b32 s58, v36, 63
    s_nop 1
    v_fmac_f32 v38, s58, v39
    v_exp_f32 v38, v38
    s_nop 0
    v_mul_f32 v33, v38, v33
    v_mul_f32 v24, v38, v24
    v_mul_f32 v26, v38, v26
    v_mul_f32 v25, v38, v25
    v_mul_f32 v27, v38, v27
    v_add_f32_dpp v33, v33, v33 row_ror:8 row_mask:0xf bank_mask:0xf
    v_permlane32_swap_b32 v24, v26
    v_permlane32_swap_b32 v25, v27
    v_add_f32_dpp v33, v33, v33 row_ror:4 row_mask:0xf bank_mask:0xf
    v_add_f32 v24, v24, v26
    v_add_f32 v25, v25, v27
    v_add_f32_dpp v33, v33, v33 quad_perm:[2,3,0,1] row_mask:0xf bank_mask:0xf
    s_nop 0
    v_permlane16_swap_b32 v24, v25
    v_add_f32_dpp v33, v33, v33 row_bcast:15 row_mask:0xa bank_mask:0xf
    v_add_f32 v24, v24, v25
    s_nop 0
    v_add_f32_dpp v33, v33, v33 row_bcast:31 row_mask:0xc bank_mask:0xf
    v_add_f32_dpp v24, v24, v24 row_ror:8 row_mask:0xf bank_mask:0xf
    v_rcp_f32 v33, v33
    s_nop 0
    v_add_f32_dpp v24, v24, v24 row_ror:4 row_mask:0xf bank_mask:0xf
    v_readlane_b32 s58, v33, 63
    s_nop 0
    v_add_f32_dpp v24, v24, v24 quad_perm:[2,3,0,1] row_mask:0xf bank_mask:0xf
    v_mul_f32 v24, s58, v24
    v_cvt_pk_bf16_f32 v24, v24, v24
    ds_write_b16 v196, v24
    s_waitcnt lgkmcnt(0)
    s_barrier
    ds_read_b128 v[72:75], v200 offset:0
    ds_read_b128 v[76:79], v200 offset:512
    ds_read_b128 v[80:83], v200 offset:1024
    ds_read_b128 v[84:87], v200 offset:1536
    ds_read_b128 v[88:91], v200 offset:2048
    ds_read_b128 v[92:95], v200 offset:2560
    ds_read_b128 v[96:99], v200 offset:3072
    ds_read_b128 v[100:103], v200 offset:3584
    s_waitcnt lgkmcnt(7)
    v_mfma_f32_16x16x32_bf16 v[60:63], v[72:75], v[160:163], 0
    s_waitcnt lgkmcnt(6)
    v_mfma_f32_16x16x32_bf16 v[60:63], v[76:79], v[164:167], v[60:63]
    s_waitcnt lgkmcnt(5)
    v_mfma_f32_16x16x32_bf16 v[60:63], v[80:83], v[168:171], v[60:63]
    s_waitcnt lgkmcnt(4)
    v_mfma_f32_16x16x32_bf16 v[60:63], v[84:87], v[172:175], v[60:63]
    s_waitcnt lgkmcnt(3)
    v_mfma_f32_16x16x32_bf16 v[60:63], v[88:91], v[176:179], v[60:63]
    s_waitcnt lgkmcnt(2)
    v_mfma_f32_16x16x32_bf16 v[60:63], v[92:95], v[180:183], v[60:63]
    s_waitcnt lgkmcnt(1)
    v_mfma_f32_16x16x32_bf16 v[60:63], v[96:99], v[184:187], v[60:63]
    s_waitcnt lgkmcnt(0)
    v_mfma_f32_16x16x32_bf16 v[60:63], v[100:103], v[188:191], v[60:63]
    v_add_u32 v40, 0x2000, v197
    v_add_u32 v46, s75, v10
    v_add_u32 v45, 262144, v46
    v_mov_b32 v43, s32
    s_mov_b32 exec_hi, 0
    s_nop 2
    v_bfi_b32 v60, v8, s50, v60
    v_bfi_b32 v61, v8, s51, v61
    v_bfi_b32 v62, v8, s52, v62
    v_bfi_b32 v63, v8, s53, v63
    s_cbranch_scc1 L_slow5
    global_store_dwordx4 v195, v[60:63], s[26:27] nt
L_back5:
    s_mov_b64 exec, -1
    s_cmp_ge_u32 s29, s88
    s_cbranch_scc1 L_fin
    s_barrier
    global_load_dwordx4 v[96:99], v197, s[20:21] offset:-4096 nt
    global_load_dwordx4 v[100:103], v197, s[20:21] offset:0 nt
    global_load_dwordx4 v[104:107], v40, s[20:21] offset:-4096 nt
    global_load_dwordx4 v[108:111], v40, s[20:21] offset:0 nt
    s_cmp_eq_u32 s30, 0
    s_cselect_b32 exec_lo, 65535, 1
    s_cselect_b32 exec_hi, 3, 0
    global_load_dword v3, v204, s[26:27] sc1
    s_mov_b64 exec, -1
    v_not_b32 v24, s34
    v_not_b32 v25, s35
    v_not_b32 v26, s36
    v_not_b32 v27, s37
    s_mov_b32 exec_hi, 0
    global_store_dwordx4 v198, v[24:27], s[26:27] sc1
    s_mov_b64 exec, -1
    s_lshl_b32 s58, s28, 8
    s_lshl_b32 s59, s57, 4
    s_add_u32 s58, s58, s59
    s_lshl_b32 s59, s30, 2
    s_add_u32 s58, s58, s59
    s_add_u32 s58, s58, 180224
    v_mov_b32 v44, s58
    s_waitcnt vmcnt(0)
    s_add_u32 s58, s69, 264192
    v_and_b32 v45, 7, v1
    v_lshl_add_u32 v45, v45, 4, s58
    v_lshrrev_b32 v47, 3, v1
    v_lshl_add_u32 v45, v47, 12, v45
    v_xor_b32 v47, s57, v47
    v_lshl_add_u32 v45, v47, 7, v45
    v_xor_b32 v47, 0x8400, v45
L_c_poll:
    global_load_dwordx4 v[72:75], v45, s[26:27] offset:0 sc1
    global_load_dwordx4 v[76:79], v47, s[26:27] offset:0 sc1
    s_add_u32 s43, s43, 1
    s_cmp_gt_u32 s43, 200000
    s_cbranch_scc1 L_end
    s_waitcnt vmcnt(0)
    v_xor_b32 v72, s50, v72
    v_xor_b32 v73, s51, v73
    v_xor_b32 v74, s52, v74
    v_xor_b32 v75, s53, v75
    v_xor_b32 v76, s50, v76
    v_xor_b32 v77, s51, v77
    v_xor_b32 v78, s52, v78
    v_xor_b32 v79, s53, v79
    v_add_f32 v80, v72, v76
    v_add_f32 v82, v74, v78
    v_add_f32 v81, v73, v77
    v_add_f32 v83, v75, v79
    v_or3_b32 v36, v72, v73, v74
    v_permlane32_swap_b32 v80, v82
    v_permlane32_swap_b32 v81, v83
    v_add_f32 v80, v80, v82
    v_add_f32 v81, v81, v83
    v_or3_b32 v36, v75, v76, v36
    v_or3_b32 v36, v77, v78, v36
    v_permlane16_swap_b32 v80, v81
    v_add_f32 v80, v80, v81
    v_bitop3_b32 v36, v79, v36, v8 bitop3:0xa8
    v_cmp_ne_u32 vcc, 0, v36
    v_add_f32_dpp v92, v80, v80 row_ror:8 row_mask:0xf bank_mask:0xf
    s_cbranch_vccnz L_c_poll
L_a1_poll:
    global_load_dwordx4 v[84:87], v199, s[26:27] sc1
    global_load_dwordx4 v[72:75], v46, s[26:27] offset:0 sc1
    global_load_dwordx4 v[76:79], v46, s[26:27] offset:1024 sc1
    s_add_u32 s43, s43, 1
    s_cmp_gt_u32 s43, 200000
    s_cbranch_scc1 L_end
    s_waitcnt vmcnt(0)
    v_xor_b32 v84, s34, v84
    v_xor_b32 v72, s34, v72
    v_xor_b32 v76, s34, v76
    v_or_b32 v36, v72, v76
    v_bitop3_b32 v36, v84, v36, v8 bitop3:0xa8
    v_cmp_ne_u32 vcc, 0, v36
    v_xor_b32 v85, s35, v85
    s_cbranch_vccnz L_a1_poll
    v_xor_b32 v86, s36, v86
    v_xor_b32 v87, s37, v87
    v_xor_b32 v73, s35, v73
    v_xor_b32 v74, s36, v74
    v_xor_b32 v75, s37, v75
    v_xor_b32 v77, s35, v77
    v_xor_b32 v78, s36, v78
    v_xor_b32 v79, s37, v79
    v_mul_f32 v90, v84, v84
    v_add_f32_dpp v88, v84, v84 quad_perm:[1,0,3,2] row_mask:0xf bank_mask:0xf
    v_add_f32_dpp v89, v85, v85 quad_perm:[1,0,3,2] row_mask:0xf bank_mask:0xf
    v_add_f32_dpp v90, v90, v90 quad_perm:[1,0,3,2] row_mask:0xf bank_mask:0xf
    v_add_f32 v80, v72, v76
    v_add_f32_dpp v88, v88, v88 quad_perm:[2,3,0,1] row_mask:0xf bank_mask:0xf
    v_add_f32_dpp v89, v89, v89 quad_perm:[2,3,0,1] row_mask:0xf bank_mask:0xf
    v_add_f32_dpp v90, v90, v90 quad_perm:[2,3,0,1] row_mask:0xf bank_mask:0xf
    v_add_f32 v82, v74, v78
    v_add_f32_dpp v88, v88, v88 row_half_mirror row_mask:0xf bank_mask:0xf
    v_add_f32_dpp v89, v89, v89 row_half_mirror row_mask:0xf bank_mask:0xf
    v_add_f32_dpp v90, v90, v90 row_half_mirror row_mask:0xf bank_mask:0xf
    v_add_f32 v81, v73, v77
    v_add_f32_dpp v88, v88, v88 row_mirror row_mask:0xf bank_mask:0xf
    v_add_f32_dpp v90, v90, v90 row_mirror row_mask:0xf bank_mask:0xf
    v_add_f32_dpp v89, v89, v89 row_mirror row_mask:0xf bank_mask:0xf
    v_add_f32 v83, v75, v79
    v_mul_f32 v88, 0x3d800000, v88
    v_mul_f32 v90, 0x3d800000, v90
    v_permlane32_swap_b32 v80, v82
    v_fma_f32 v90, -v88, v88, v90
    v_permlane32_swap_b32 v81, v83
    v_fmac_f32 v90, 0x3b000000, v89
    v_add_f32 v80, v80, v82
    v_cvt_pk_bf16_f32 v90, 0, v90
    v_add_f32 v81, v81, v83
    v_add_f32 v90, 0x3727c5ac, v90
    v_or3_b32 v36, v85, v86, v87
    v_cvt_pk_bf16_f32 v90, 0, v90
    v_permlane16_swap_b32 v80, v81
    v_sqrt_f32 v90, v90
    v_add_f32 v80, v80, v81
    v_cvt_pk_bf16_f32 v90, 0, v90
    v_cvt_pk_bf16_f32 v88, 0, v88
    v_rcp_f32 v90, v90
    v_add_f32_dpp v80, v80, v80 row_ror:8 row_mask:0xf bank_mask:0xf
    v_fma_f32 v80, -v88, v92, v80
    v_mul_f32_e64 v80, v80, v90
    v_cvt_pk_bf16_f32 v80, 0, v80
    v_or3_b32 v36, v73, v74, v36
    v_or3_b32 v36, v75, v77, v36
    v_mul_f32_dpp v80, v80, v80 quad_perm:[2,3,2,3] row_mask:0xf bank_mask:0xf
    v_cvt_pk_bf16_f32 v80, v80, v80
    v_or3_b32 v36, v78, v79, v36
    v_bitop3_b32 v36, v85, v36, v8 bitop3:0xa8
    v_cmp_ne_u32 vcc, 0, v36
    s_cbranch_vccnz L_a1_poll
    s_cmp_lg_u32 s42, 0
    v_and_b32_dpp v60, v80, v4 row_newbcast:0 row_mask:0xf bank_mask:0xf
    v_and_b32_dpp v61, v80, v5 row_newbcast:0 row_mask:0xf bank_mask:0xf
    v_and_b32_dpp v62, v80, v6 row_newbcast:0 row_mask:0xf bank_mask:0xf
    v_and_b32_dpp v63, v80, v7 row_newbcast:0 row_mask:0xf bank_mask:0xf
    v_and_b32_dpp v64, v80, v4 row_newbcast:1 row_mask:0xf bank_mask:0xf
    v_and_b32_dpp v65, v80, v5 row_newbcast:1 row_mask:0xf bank_mask:0xf
    v_and_b32_dpp v66, v80, v6 row_newbcast:1 row_mask:0xf bank_mask:0xf
    v_and_b32_dpp v67, v80, v7 row_newbcast:1 row_mask:0xf bank_mask:0xf
    v_mfma_f32_16x16x32_bf16 v[24:27], v[60:63], v[96:99], 0
    v_and_b32_dpp v68, v80, v4 row_newbcast:4 row_mask:0xf bank_mask:0xf
    v_and_b32_dpp v69, v80, v5 row_newbcast:4 row_mask:0xf bank_mask:0xf
    v_and_b32_dpp v70, v80, v6 row_newbcast:4 row_mask:0xf bank_mask:0xf
    v_and_b32_dpp v71, v80, v7 row_newbcast:4 row_mask:0xf bank_mask:0xf
    v_mfma_f32_16x16x32_bf16 v[24:27], v[64:67], v[100:103], v[24:27]
    v_and_b32_dpp v72, v80, v4 row_newbcast:5 row_mask:0xf bank_mask:0xf
    v_and_b32_dpp v73, v80, v5 row_newbcast:5 row_mask:0xf bank_mask:0xf
    v_and_b32_dpp v74, v80, v6 row_newbcast:5 row_mask:0xf bank_mask:0xf
    v_and_b32_dpp v75, v80, v7 row_newbcast:5 row_mask:0xf bank_mask:0xf
    v_mfma_f32_16x16x32_bf16 v[24:27], v[68:71], v[104:107], v[24:27]
    s_nop 0
    v_mfma_f32_16x16x32_bf16 v[24:27], v[72:75], v[108:111], v[24:27]
    s_mov_b64 exec, 1
    s_cbranch_scc1 L_slow6
    global_store_dword v44, v43, s[26:27] nt
L_back6:
    s_mov_b32 exec_lo, -1
    s_mov_b32 exec_hi, 0
    s_nop 2
    v_bfi_b32 v24, v8, s34, v24
    v_bfi_b32 v25, v8, s35, v25
    v_bfi_b32 v26, v8, s36, v26
    v_bfi_b32 v27, v8, s37, v27
    global_store_dwordx4 v198, v[24:27], s[26:27] sc1
    s_endpgm
L_q_retry:
    s_cmp_lg_u64 s[66:67], 0
    s_cbranch_scc1 L_q_ra
    s_cmp_eq_u64 s[82:83], 0
    s_cbranch_scc1 L_q_ra
    v_or_b32 v11, 131072, v11
L_q_ra:
    global_load_dwordx4 v[24:27], v11, s[26:27] sc1
    global_load_dwordx4 v[32:35], v11, s[26:27] offset:2048 sc1
    global_load_dword v36, v12, s[48:49] sc1
    s_add_u32 s43, s43, 1
    s_cmp_gt_u32 s43, 200000
    s_cbranch_scc1 L_end
    s_waitcnt vmcnt(0)
    s_branch L_qchk
L_slow1:
    global_store_dwordx4 v192, v[60:63], s[26:27] sc1
    s_branch L_back1
L_slow2:
    global_store_dwordx4 v204, v[60:63], s[26:27] sc1
    s_branch L_back2
L_slow3:
    global_store_dwordx4 v198, v[60:63], s[26:27] sc1
    s_branch L_back3
L_slow4:
    global_store_dwordx4 v199, v[32:35], s[26:27] sc1
    s_branch L_back4
L_slow5:
    global_store_dwordx4 v195, v[60:63], s[26:27] sc1
    s_branch L_back5
L_slow6:
    global_store_dword v44, v43, s[26:27] sc1
    s_branch L_back6
L_end:
    s_endpgm
.section .rodata,"a"
.p2align 6
.amdhsa_kernel sequential_preLN__sliding_block_cached__glu_gated_bilinear__decode_kernel
  .amdhsa_next_free_vgpr 208
  .amdhsa_next_free_sgpr 102
  .amdhsa_accum_offset 208
  .amdhsa_group_segment_fixed_size 0
  .amdhsa_kernarg_size 96
  .amdhsa_user_sgpr_count 2
  .amdhsa_user_sgpr_kernarg_segment_ptr 1
  .amdhsa_system_sgpr_workgroup_id_x 1
.end_amdhsa_kernel
```
